```python
import torch

def _softmax(x, axis=-1):
    return torch.softmax(x, dim=axis)
def _gelu(x):
    return torch.nn.functional.gelu(x, approximate="tanh")
def _silu(x):
    return torch.nn.functional.silu(x)
def _sigmoid(x):
    return torch.sigmoid(x)
def _layernorm(x, axis=-1, eps=1e-5):
    m = x.mean(dim=axis, keepdim=True)
    v = x.var(dim=axis, keepdim=True, unbiased=False)
    return (x - m) / torch.sqrt(v + eps)
def _scatter_add(tgt, idx, src, axis=0):
    return tgt.clone().index_add_(axis, idx, src)
def _segment_sum(src, seg, n):
    out = torch.zeros((n,) + src.shape[1:], dtype=src.dtype)
    return out.index_add_(0, seg, src)
def _pad(x, pw):
    flat = tuple(v for pair in reversed(pw) for v in pair)
    return torch.nn.functional.pad(x, flat)

kernel_name = 'gated_mix__sliding_block_cached__gqa_block_cached__decode'

def setup_inputs():

    _w = (lambda a: (lambda t: t.to(torch.bfloat16) if t.is_floating_point() else t)(torch.as_tensor(a)))
    def _A_setup():
        B, Sq, D = 2, 1, 512
        Hq, Hkv, Sk, Dh = 32, 8, 32768, 128
        assert Hq % Hkv == 0, (Hq, Hkv)
        return {
            "x": _w((lambda *s: torch.randn(*s, dtype=torch.bfloat16) * 0.05)(B, Sq, D)),
            "k_cache": _w((lambda *s: torch.randn(*s, dtype=torch.bfloat16) * 6.4)(B, Hkv, Sk, Dh)),
            "v_cache": _w((lambda *s: torch.randn(*s, dtype=torch.bfloat16) * 0.05)(B, Hkv, Sk, Dh)),
            "wq": _w((lambda *s: torch.randn(*s, dtype=torch.bfloat16) * 6.4)(D, Hq * Dh) * (D ** -0.5)),
            "wo": _w((lambda *s: torch.randn(*s, dtype=torch.bfloat16) * 0.05)(Hq * Dh, D) * ((Hq * Dh) ** -0.5)),
        }
    _A_in = _A_setup()

    def _B_setup():
        B, Sq, D = 2, 1, 512
        Hq, Hkv, Sk, Dh = 32, 8, 32768, 128
        assert Hq % Hkv == 0, (Hq, Hkv)
        return {
            "x": _w((lambda *s: torch.randn(*s, dtype=torch.bfloat16) * 0.05)(B, Sq, D)),
            "k_cache": _w((lambda *s: torch.randn(*s, dtype=torch.bfloat16) * 6.4)(B, Hkv, Sk, Dh)),
            "v_cache": _w((lambda *s: torch.randn(*s, dtype=torch.bfloat16) * 0.05)(B, Hkv, Sk, Dh)),
            "wq": _w((lambda *s: torch.randn(*s, dtype=torch.bfloat16) * 6.4)(D, Hq * Dh) * (D ** -0.5)),
            "wo": _w((lambda *s: torch.randn(*s, dtype=torch.bfloat16) * 0.05)(Hq * Dh, D) * ((Hq * Dh) ** -0.5)),
        }
    _B_in = _B_setup()

    return {
        "A_x": _A_in["x"],
        "A_k_cache": _A_in["k_cache"],
        "A_v_cache": _A_in["v_cache"],
        "A_wq": _A_in["wq"],
        "A_wo": _A_in["wo"],
        "B_x": _B_in["x"],
        "B_k_cache": _B_in["k_cache"],
        "B_v_cache": _B_in["v_cache"],
        "B_wq": _B_in["wq"],
        "B_wo": _B_in["wo"],
        "gate_w": _w((lambda *s: torch.randn(*s, dtype=torch.bfloat16) * 0.05)(512) * 16.0),
    }

def reference(A_x, A_k_cache, A_v_cache, A_wq, A_wo, B_x, B_k_cache, B_v_cache, B_wq, B_wo, gate_w):
    def _A_ref(x, k_cache, v_cache, wq, wo):
        B, Sq, D = x.shape
        Hq, Dh = 32, 128
        Hkv, Sk = k_cache.shape[1], k_cache.shape[2]
        W = min(4096, max(256, Sk // 4))
        rep = Hq // Hkv
        q = (lambda x, *d: x.permute(*d))((x @ wq).reshape(B, Sq, Hq, Dh), 0, 2, 1, 3)
        k = (lambda x, n, axis: torch.repeat_interleave(x, n, dim=axis))(k_cache[:, :, Sk - W:, :], rep, axis=1)
        v = (lambda x, n, axis: torch.repeat_interleave(x, n, dim=axis))(v_cache[:, :, Sk - W:, :], rep, axis=1)
        scores = torch.einsum("bhqd,bhkd->bhqk", q, k) * (Dh ** -0.5)
        p = _softmax(scores, axis=-1)
        o = torch.einsum("bhqk,bhkd->bhqd", p, v)
        return (lambda x, *d: x.permute(*d))(o, 0, 2, 1, 3).reshape(B, Sq, Hq * Dh) @ wo

    def _B_ref(x, k_cache, v_cache, wq, wo):
        B, Sq, D = x.shape
        Hq, Dh = 32, 128
        Hkv = k_cache.shape[1]
        rep = Hq // Hkv
        q = (lambda x, *d: x.permute(*d))((x @ wq).reshape(B, Sq, Hq, Dh), 0, 2, 1, 3)
        k = (lambda x, n, axis: torch.repeat_interleave(x, n, dim=axis))(k_cache, rep, axis=1)
        v = (lambda x, n, axis: torch.repeat_interleave(x, n, dim=axis))(v_cache, rep, axis=1)
        scores = torch.einsum("bhqd,bhkd->bhqk", q, k) * (Dh ** -0.5)
        p = _softmax(scores, axis=-1)
        o = torch.einsum("bhqk,bhkd->bhqd", p, v)
        return (lambda x, *d: x.permute(*d))(o, 0, 2, 1, 3).reshape(B, Sq, Hq * Dh) @ wo

    x = A_x
    g = _sigmoid((x * gate_w).sum(-1, keepdims=True))
    a = _A_ref(x, A_k_cache, A_v_cache, A_wq, A_wo)
    b = _B_ref(x, B_k_cache, B_v_cache, B_wq, B_wo)
    return g * a + (1 - g) * b
```

```asm
; @launch grid=(256,1,1) block=(512,1,1) lds=163840
.amdgcn_target "amdgcn-amd-amdhsa--gfx950"
.text
.globl gated_mix__sliding_block_cached__gqa_block_cached__decode_kernel
.p2align 8
.type gated_mix__sliding_block_cached__gqa_block_cached__decode_kernel,@function
gated_mix__sliding_block_cached__gqa_block_cached__decode_kernel:
  s_cmp_ge_u32 s2, 256
  s_cbranch_scc1 L_end
  s_load_dwordx16 s[16:31], s[0:1], 0
  s_load_dwordx8 s[32:39], s[0:1], 64
  s_load_dwordx4 s[40:43], s[0:1], 96
  v_lshrrev_b32 v1, 6, v0
  v_and_b32 v0, 63, v0
  v_readfirstlane_b32 s3, v1
  s_lshr_b32 s4, s2, 4
  s_and_b32 s5, s2, 15
  s_lshr_b32 s6, s4, 3
  s_and_b32 s7, s4, 7
  s_and_b32 s13, s5, 9
  v_lshrrev_b32 v1, 4, v0
  v_and_b32 v2, 15, v0
  s_cmp_lt_u32 s3, 4
  s_cbranch_scc1 L_helper
  s_sub_u32 s3, s3, 4
  s_lshl_b32 s60, s3, 15
  v_lshlrev_b32 v5, 1, v1
  v_xor_b32 v6, v2, v5
  v_lshlrev_b32 v7, 4, v6
  v_lshl_add_u32 v3, v1, 8, v7
  v_xor_b32 v4, 0x80, v3
  v_mov_b32 v142, v3
  v_mov_b32 v143, v4
  s_lshl_b32 s86, s4, 23
  s_lshl_b32 s8, s3, 12
  s_or_b32 s86, s86, s8
  s_lshr_b32 s9, s5, 1
  s_sub_u32 s10, s5, 4
  s_cmp_lt_u32 s5, 8
  s_cselect_b32 s9, s9, s10
  s_lshl_b32 s61, s9, 14
  s_mul_i32 s84, s4, 655360
  s_mov_b32 s46, 0x8000000
  s_mov_b32 s47, 0x20000
  s_mov_b32 s50, 0x8000000
  s_mov_b32 s51, 0x20000
  s_mov_b32 s85, 0x7fffff
  s_mov_b32 s62, 196608
  s_cmp_eq_u32 s13, 0
  s_cselect_b32 s62, 65536, s62
  s_cselect_b32 s81, 7340032, s84
  s_waitcnt lgkmcnt(0)
  s_cselect_b32 s44, s18, s28
  s_cselect_b32 s45, s19, s29
  s_cselect_b32 s48, s20, s30
  s_cselect_b32 s49, s21, s31
  s_and_b32 s45, s45, 0xffff
  s_and_b32 s49, s49, 0xffff
  s_barrier
  s_mov_b32 m0, s60
  s_add_u32 s72, s61, s81
  s_and_b32 s72, s72, s85
  s_or_b32 s72, s72, s86
  buffer_load_dwordx4 v3, s[44:47], s72 offen offset:0 nt lds
  buffer_load_dwordx4 v4, s[44:47], s72 offen offset:1024 nt lds
  buffer_load_dwordx4 v142, s[44:47], s72 offen offset:2048 nt lds
  buffer_load_dwordx4 v143, s[44:47], s72 offen offset:3072 nt lds
  s_add_u32 m0, m0, 4096
  s_nop 0
  buffer_load_dwordx4 v3, s[48:51], s72 offen offset:0 nt lds
  buffer_load_dwordx4 v4, s[48:51], s72 offen offset:1024 nt lds
  buffer_load_dwordx4 v142, s[48:51], s72 offen offset:2048 nt lds
  buffer_load_dwordx4 v143, s[48:51], s72 offen offset:3072 nt lds
  s_add_u32 s61, s61, s62
  v_and_b32 v5, 7, v2
  v_lshlrev_b32 v5, 1, v5
  v_xor_b32 v5, v5, v1
  v_lshlrev_b32 v5, 4, v5
  v_lshl_add_u32 v5, v2, 8, v5
  v_add_u32 v8, s60, v5
  v_xor_b32 v9, 64, v8
  v_xor_b32 v10, 0x80, v8
  v_xor_b32 v11, 0xc0, v8
  v_lshrrev_b32 v5, 2, v0
  v_and_b32 v6, 7, v5
  v_lshlrev_b32 v6, 5, v6
  v_lshl_add_u32 v5, v5, 8, v6
  v_and_b32 v6, 3, v0
  v_lshl_add_u32 v5, v6, 3, v5
  s_add_u32 s9, s60, 4096
  v_add_u32 v12, s9, v5
  v_xor_b32 v13, 32, v12
  v_xor_b32 v14, 64, v12
  v_xor_b32 v15, 96, v12
  v_xor_b32 v16, 128, v12
  v_xor_b32 v17, 160, v12
  v_xor_b32 v18, 192, v12
  v_xor_b32 v19, 224, v12
  v_lshlrev_b32 v5, 9, v2
  v_lshl_add_u32 v5, v1, 4, v5
  s_add_u32 s9, s60, 24576
  v_add_u32 v136, s9, v5
  v_lshlrev_b32 v5, 3, v2
  s_add_u32 s9, s9, 2048
  v_add_u32 v137, s9, v5
  v_mov_b32 v134, 0x3f803f80
  v_mov_b32 v135, 0x3f803f80
  s_mov_b32 s70, 0x3db504f3
  s_mov_b32 s71, 0x3fb8aa3b
  s_lshl_b32 s9, s4, 2
  s_add_u32 s9, s9, s3
  s_lshl_b32 s9, s9, 8
  s_add_u32 s9, s9, 4096
  s_add_u32 s68, s42, s9
  s_addc_u32 s69, s43, 0
  v_and_b32 v5, 3, v2
  v_lshlrev_b32 v5, 8, v5
  v_lshl_add_u32 v5, v1, 4, v5
  v_add_u32 v5, 131072, v5
  s_cmp_eq_u32 s13, 0
  s_cselect_b32 s9, 0, 1024
  v_add_u32 v6, s9, v5
  v_lshl_add_u32 v138, v1, 10, v7
  v_xor_b32 v139, 0x80, v138
  v_add_u32 v139, 3072, v139
  v_add_u32 v140, 6144, v138
  v_add_u32 v141, 6144, v139
  s_and_b32 s9, s5, 7
  s_lshl_b32 s10, s7, 3
  s_add_u32 s9, s9, s10
  s_lshl_b32 s52, s9, 16
  s_lshl_b32 s9, s3, 14
  s_add_u32 s52, s52, s9
  s_lshr_b32 s9, s5, 3
  s_lshl_b32 s10, s6, 1
  s_add_u32 s9, s9, s10
  s_lshl_b32 s9, s9, 8
  s_add_u32 s52, s52, s9
  v_mov_b32 v144, 27392
  s_mov_b32 s63, 11
  s_mov_b32 s75, 0
  s_mov_b32 s76, 0
  s_mov_b32 s66, 0
  s_mov_b32 s87, 0
  s_mov_b32 s80, 1
  s_mov_b32 s65, 1
  v_mov_b32 v88, 0
  v_mov_b32 v89, 0
  v_mov_b32 v90, 0
  v_mov_b32 v91, 0
  v_mov_b32 v92, 0
  v_mov_b32 v93, 0
  v_mov_b32 v94, 0
  v_mov_b32 v95, 0
  v_mov_b32 v96, 0
  v_mov_b32 v97, 0
  v_mov_b32 v98, 0
  v_mov_b32 v99, 0
  v_mov_b32 v100, 0
  v_mov_b32 v101, 0
  v_mov_b32 v102, 0
  v_mov_b32 v103, 0
  v_mov_b32 v104, 0
  v_mov_b32 v105, 0
  v_mov_b32 v106, 0
  v_mov_b32 v107, 0
  v_mov_b32 v108, 0
  v_mov_b32 v109, 0
  v_mov_b32 v110, 0
  v_mov_b32 v111, 0
  v_mov_b32 v112, 0
  v_mov_b32 v113, 0
  v_mov_b32 v114, 0
  v_mov_b32 v115, 0
  v_mov_b32 v116, 0
  v_mov_b32 v117, 0
  v_mov_b32 v118, 0
  v_mov_b32 v119, 0
  v_mov_b32 v120, 0
  v_mov_b32 v121, 0
  v_mov_b32 v122, 0
  v_mov_b32 v123, 0
  v_mov_b32 v124, 0xff800000
  v_mov_b32 v126, 0xff800000
  s_barrier
  s_barrier
  s_add_u32 m0, s60, 8192
  s_add_u32 s72, s61, s81
  s_and_b32 s72, s72, s85
  s_or_b32 s72, s72, s86
  buffer_load_dwordx4 v3, s[44:47], s72 offen offset:0 nt lds
  buffer_load_dwordx4 v4, s[44:47], s72 offen offset:1024 nt lds
  buffer_load_dwordx4 v142, s[44:47], s72 offen offset:2048 nt lds
  buffer_load_dwordx4 v143, s[44:47], s72 offen offset:3072 nt lds
  s_add_u32 m0, m0, 4096
  s_nop 0
  buffer_load_dwordx4 v3, s[48:51], s72 offen offset:0 nt lds
  buffer_load_dwordx4 v4, s[48:51], s72 offen offset:1024 nt lds
  buffer_load_dwordx4 v142, s[48:51], s72 offen offset:2048 nt lds
  buffer_load_dwordx4 v143, s[48:51], s72 offen offset:3072 nt lds
  s_add_u32 s61, s61, s62
  s_add_u32 m0, s60, 16384
  s_add_u32 s72, s61, s81
  s_and_b32 s72, s72, s85
  s_or_b32 s72, s72, s86
  buffer_load_dwordx4 v3, s[44:47], s72 offen offset:0 nt lds
  buffer_load_dwordx4 v4, s[44:47], s72 offen offset:1024 nt lds
  buffer_load_dwordx4 v142, s[44:47], s72 offen offset:2048 nt lds
  buffer_load_dwordx4 v143, s[44:47], s72 offen offset:3072 nt lds
  s_add_u32 m0, m0, 4096
  s_nop 0
  buffer_load_dwordx4 v3, s[48:51], s72 offen offset:0 nt lds
  buffer_load_dwordx4 v4, s[48:51], s72 offen offset:1024 nt lds
  buffer_load_dwordx4 v142, s[48:51], s72 offen offset:2048 nt lds
  buffer_load_dwordx4 v143, s[48:51], s72 offen offset:3072 nt lds
  s_add_u32 s61, s61, s62
  s_add_u32 m0, s60, 24576
  s_add_u32 s72, s61, s81
  s_and_b32 s72, s72, s85
  s_or_b32 s72, s72, s86
  buffer_load_dwordx4 v3, s[44:47], s72 offen offset:0 nt lds
  buffer_load_dwordx4 v4, s[44:47], s72 offen offset:1024 nt lds
  buffer_load_dwordx4 v142, s[44:47], s72 offen offset:2048 nt lds
  buffer_load_dwordx4 v143, s[44:47], s72 offen offset:3072 nt lds
  s_add_u32 m0, m0, 4096
  s_nop 0
  buffer_load_dwordx4 v3, s[48:51], s72 offen offset:0 nt lds
  buffer_load_dwordx4 v4, s[48:51], s72 offen offset:1024 nt lds
  buffer_load_dwordx4 v142, s[48:51], s72 offen offset:2048 nt lds
  buffer_load_dwordx4 v143, s[48:51], s72 offen offset:3072 nt lds
  s_add_u32 s61, s61, s62
  s_barrier
  ds_read_b128 v[20:23], v6 offset:0
  ds_read_b128 v[24:27], v6 offset:64
  ds_read_b128 v[28:31], v6 offset:128
  ds_read_b128 v[32:35], v6 offset:192
  ds_read_b128 v[36:39], v5 offset:1024
  ds_read_b128 v[40:43], v5 offset:1088
  ds_read_b128 v[44:47], v5 offset:1152
  ds_read_b128 v[48:51], v5 offset:1216
L_loop:
  s_movk_i32 s67, 0x2000
  s_cmp_eq_u32 s66, 16384
  s_cselect_b32 s67, 4294950912, s67
  s_cmp_lt_u32 s76, 4
  s_cbranch_scc1 L_first
  s_waitcnt vmcnt(0) lgkmcnt(0)
  s_cmp_lg_u32 s63, 0
  s_cbranch_scc1 L_stat
  s_cmp_lg_u32 s75, 0
  s_cbranch_scc1 L_dyn
  s_mov_b32 s75, 1
  s_mov_b32 s44, s28
  s_and_b32 s45, s29, 0xffff
  s_mov_b32 s48, s30
  s_and_b32 s49, s31, 0xffff
  s_lshl_b32 s61, s5, 14
  s_add_u32 s61, s61, 3145728
  s_mov_b32 s81, s84
  s_mov_b32 s62, 262144
  s_mov_b32 s63, 15
L_stat:
  s_mov_b32 s73, s61
  s_add_u32 s61, s61, s62
  s_sub_u32 s63, s63, 1
  s_xor_b32 s9, s75, 1
  s_or_b32 s80, s9, s63
  s_branch L_iss
L_dyn:
  s_lshl_b32 s73, s64, 14
  s_add_u32 s73, s73, 7077888
  s_mov_b32 s80, 0
  s_cmp_lt_u32 s64, 80
  s_cbranch_scc1 L_iss
  s_mov_b32 s80, 1
  s_mov_b32 s65, 0
  s_branch L_read
L_iss:
  s_add_u32 m0, s60, s87
  s_add_u32 s72, s73, s81
  s_and_b32 s72, s72, s85
  s_or_b32 s72, s72, s86
  buffer_load_dwordx4 v3, s[44:47], s72 offen offset:0 nt lds
  buffer_load_dwordx4 v4, s[44:47], s72 offen offset:1024 nt lds
  buffer_load_dwordx4 v142, s[44:47], s72 offen offset:2048 nt lds
  buffer_load_dwordx4 v143, s[44:47], s72 offen offset:3072 nt lds
  s_add_u32 m0, m0, 4096
  s_nop 0
  buffer_load_dwordx4 v3, s[48:51], s72 offen offset:0 nt lds
  buffer_load_dwordx4 v4, s[48:51], s72 offen offset:1024 nt lds
  buffer_load_dwordx4 v142, s[48:51], s72 offen offset:2048 nt lds
  buffer_load_dwordx4 v143, s[48:51], s72 offen offset:3072 nt lds
  s_add_u32 s87, s87, 0x2000
  s_cmp_eq_u32 s87, 24576
  s_cselect_b32 s87, 0, s87
  s_cmp_gt_u32 s65, 1
  s_cbranch_scc1 L_wodone
L_read:
  ds_read_b128 v[52:55], v8
  ds_read_b128 v[56:59], v9
  ds_read_b128 v[60:63], v10
  ds_read_b128 v[64:67], v11
  ds_read_b64_tr_b16 v[68:69], v12
  ds_read_b64_tr_b16 v[70:71], v13
  ds_read_b64_tr_b16 v[72:73], v14
  ds_read_b64_tr_b16 v[74:75], v15
  ds_read_b64_tr_b16 v[76:77], v16
  ds_read_b64_tr_b16 v[78:79], v17
  ds_read_b64_tr_b16 v[80:81], v18
  ds_read_b64_tr_b16 v[82:83], v19
  v_add_u32 v8, s67, v8
  v_add_u32 v9, s67, v9
  v_add_u32 v10, s67, v10
  v_add_u32 v11, s67, v11
  v_add_u32 v12, s67, v12
  v_add_u32 v13, s67, v13
  v_add_u32 v14, s67, v14
  v_add_u32 v15, s67, v15
  v_add_u32 v16, s67, v16
  v_add_u32 v17, s67, v17
  v_add_u32 v18, s67, v18
  v_add_u32 v19, s67, v19
  s_waitcnt lgkmcnt(11)
  v_mfma_f32_16x16x32_bf16 v[84:87], v[52:55], v[20:23], 0
  s_waitcnt lgkmcnt(10)
  v_mfma_f32_16x16x32_bf16 v[84:87], v[56:59], v[24:27], v[84:87]
  s_waitcnt lgkmcnt(9)
  v_mfma_f32_16x16x32_bf16 v[84:87], v[60:63], v[28:31], v[84:87]
  s_waitcnt lgkmcnt(8)
  v_mfma_f32_16x16x32_bf16 v[84:87], v[64:67], v[32:35], v[84:87]
  s_waitcnt lgkmcnt(0)
  s_cmp_eq_u32 s76, 0
  s_cbranch_scc1 L_late
  s_cmp_lg_u32 s80, 0
  s_cbranch_scc1 L_noref
  s_mov_b32 s64, 1
  s_atomic_add s64, s[68:69], 0 glc
L_noref:
  s_add_u32 s66, s66, s67
  s_add_u32 s76, s76, 1
  s_nop 1
  v_cvt_pk_bf16_f32 v128, v84, v85
  v_cvt_pk_bf16_f32 v129, v86, v87
  v_lshlrev_b32 v84, 16, v128
  v_and_b32 v85, 0xffff0000, v128
  v_lshlrev_b32 v86, 16, v129
  v_and_b32 v87, 0xffff0000, v129
  v_mul_f32 v84, s70, v84
  v_mul_f32 v85, s70, v85
  v_mul_f32 v86, s70, v86
  v_mul_f32 v87, s70, v87
  v_cvt_pk_bf16_f32 v128, v84, v85
  v_cvt_pk_bf16_f32 v129, v86, v87
  v_lshlrev_b32 v84, 16, v128
  v_and_b32 v85, 0xffff0000, v128
  v_lshlrev_b32 v86, 16, v129
  v_and_b32 v87, 0xffff0000, v129
  v_max3_f32 v128, v84, v85, v86
  v_max_f32 v128, v128, v87
  v_cmp_gt_f32 vcc, v128, v124
  s_cbranch_vccz L_keep
  v_mov_b32 v129, v128
  s_nop 1
  v_permlane32_swap_b32 v128, v129
  v_max_f32 v128, v128, v129
  v_mov_b32 v129, v128
  s_nop 1
  v_permlane16_swap_b32 v128, v129
  v_max3_f32 v128, v128, v129, v124
  v_sub_f32 v130, v124, v128
  v_mul_f32 v130, s71, v130
  v_exp_f32 v130, v130
  v_mov_b32 v124, v128
  v_mul_f32 v126, s71, v128
  v_pk_mul_f32 v[88:89], v[88:89], v[130:131] op_sel_hi:[1,0]
  v_pk_mul_f32 v[90:91], v[90:91], v[130:131] op_sel_hi:[1,0]
  v_pk_mul_f32 v[92:93], v[92:93], v[130:131] op_sel_hi:[1,0]
  v_pk_mul_f32 v[94:95], v[94:95], v[130:131] op_sel_hi:[1,0]
  v_pk_mul_f32 v[96:97], v[96:97], v[130:131] op_sel_hi:[1,0]
  v_pk_mul_f32 v[98:99], v[98:99], v[130:131] op_sel_hi:[1,0]
  v_pk_mul_f32 v[100:101], v[100:101], v[130:131] op_sel_hi:[1,0]
  v_pk_mul_f32 v[102:103], v[102:103], v[130:131] op_sel_hi:[1,0]
  v_pk_mul_f32 v[104:105], v[104:105], v[130:131] op_sel_hi:[1,0]
  v_pk_mul_f32 v[106:107], v[106:107], v[130:131] op_sel_hi:[1,0]
  v_pk_mul_f32 v[108:109], v[108:109], v[130:131] op_sel_hi:[1,0]
  v_pk_mul_f32 v[110:111], v[110:111], v[130:131] op_sel_hi:[1,0]
  v_pk_mul_f32 v[112:113], v[112:113], v[130:131] op_sel_hi:[1,0]
  v_pk_mul_f32 v[114:115], v[114:115], v[130:131] op_sel_hi:[1,0]
  v_pk_mul_f32 v[116:117], v[116:117], v[130:131] op_sel_hi:[1,0]
  v_pk_mul_f32 v[118:119], v[118:119], v[130:131] op_sel_hi:[1,0]
  v_mul_f32 v120, v130, v120
L_keep:
  v_fma_f32 v84, v84, s71, -v126
  v_fma_f32 v85, v85, s71, -v126
  v_fma_f32 v86, v86, s71, -v126
  v_fma_f32 v87, v87, s71, -v126
  v_exp_f32 v84, v84
  v_exp_f32 v85, v85
  v_exp_f32 v86, v86
  v_exp_f32 v87, v87
  s_nop 0
  v_cvt_pk_bf16_f32 v132, v84, v85
  v_cvt_pk_bf16_f32 v133, v86, v87
  s_nop 1
  v_mfma_f32_16x16x16_bf16 v[120:123], v[134:135], v[132:133], v[120:123]
  v_mfma_f32_16x16x16_bf16 v[88:91], v[68:69], v[132:133], v[88:91]
  v_mfma_f32_16x16x16_bf16 v[92:95], v[70:71], v[132:133], v[92:95]
  v_mfma_f32_16x16x16_bf16 v[96:99], v[72:73], v[132:133], v[96:99]
  v_mfma_f32_16x16x16_bf16 v[100:103], v[74:75], v[132:133], v[100:103]
  v_mfma_f32_16x16x16_bf16 v[104:107], v[76:77], v[132:133], v[104:107]
  v_mfma_f32_16x16x16_bf16 v[108:111], v[78:79], v[132:133], v[108:111]
  v_mfma_f32_16x16x16_bf16 v[112:115], v[80:81], v[132:133], v[112:115]
  v_mfma_f32_16x16x16_bf16 v[116:119], v[82:83], v[132:133], v[116:119]
  s_cmp_eq_u32 s65, 0
  s_cbranch_scc1 L_wpart
  s_cmp_eq_u32 s76, 27
  s_cbranch_scc1 L_bar
  s_cmp_eq_u32 s76, 29
  s_cbranch_scc1 L_bar
  s_cmp_lg_u32 s76, 16
  s_cbranch_scc1 L_loop
  s_cmp_lg_u32 s13, 0
  s_cbranch_scc1 L_x1
L_wpart:
  s_mov_b32 exec_lo, 0x000f000f
  s_mov_b32 exec_hi, 0x000f000f
  v_mov_b32 v145, 1
  v_mov_b32 v127, v120
  ds_write_b128 v136, v[88:91] offset:0
  ds_write_b128 v136, v[92:95] offset:64
  ds_write_b128 v136, v[96:99] offset:128
  ds_write_b128 v136, v[100:103] offset:192
  ds_write_b128 v136, v[104:107] offset:256
  ds_write_b128 v136, v[108:111] offset:320
  ds_write_b128 v136, v[112:115] offset:384
  s_nop 0
  ds_write_b128 v136, v[116:119] offset:448
  s_mov_b64 exec, 15
  ds_write_b64 v137, v[126:127]
  s_mov_b64 exec, 1
  ds_add_rtn_u32 v145, v144, v145
  s_mov_b64 exec, -1
  s_waitcnt lgkmcnt(0)
  s_cmp_eq_u32 s65, 0
  s_cbranch_scc1 L_sdone
  v_mov_b32 v88, 0
  v_mov_b32 v89, 0
  v_mov_b32 v90, 0
  v_mov_b32 v91, 0
  v_mov_b32 v92, 0
  v_mov_b32 v93, 0
  v_mov_b32 v94, 0
  v_mov_b32 v95, 0
  v_mov_b32 v96, 0
  v_mov_b32 v97, 0
  v_mov_b32 v98, 0
  v_mov_b32 v99, 0
  v_mov_b32 v100, 0
  v_mov_b32 v101, 0
  v_mov_b32 v102, 0
  v_mov_b32 v103, 0
  v_mov_b32 v104, 0
  v_mov_b32 v105, 0
  v_mov_b32 v106, 0
  v_mov_b32 v107, 0
  v_mov_b32 v108, 0
  v_mov_b32 v109, 0
  v_mov_b32 v110, 0
  v_mov_b32 v111, 0
  v_mov_b32 v112, 0
  v_mov_b32 v113, 0
  v_mov_b32 v114, 0
  v_mov_b32 v115, 0
  v_mov_b32 v116, 0
  v_mov_b32 v117, 0
  v_mov_b32 v118, 0
  v_mov_b32 v119, 0
  v_mov_b32 v120, 0
  v_mov_b32 v121, 0
  v_mov_b32 v122, 0
  v_mov_b32 v123, 0
  v_mov_b32 v124, 0xff800000
  v_mov_b32 v126, 0xff800000
  v_mov_b32 v20, v36
  v_mov_b32 v21, v37
  v_mov_b32 v22, v38
  v_mov_b32 v23, v39
  v_mov_b32 v24, v40
  v_mov_b32 v25, v41
  v_mov_b32 v26, v42
  v_mov_b32 v27, v43
  v_mov_b32 v28, v44
  v_mov_b32 v29, v45
  v_mov_b32 v30, v46
  v_mov_b32 v31, v47
  v_mov_b32 v32, v48
  v_mov_b32 v33, v49
  v_mov_b32 v34, v50
  v_mov_b32 v35, v51
L_x1:
  v_add_u32 v136, 0x1000, v136
  v_add_u32 v137, 0x1000, v137
L_bar:
  s_barrier
  s_branch L_loop
L_first:
  s_cmp_eq_u32 s76, 3
  s_cselect_b32 s67, 4294942720, s67
  s_cmp_eq_u32 s76, 2
  s_cselect_b32 s67, 0x2000, s67
  s_waitcnt vmcnt(8) lgkmcnt(0)
  s_branch L_read
L_late:
  s_mov_b32 m0, s60
  s_add_u32 s72, s61, s81
  s_and_b32 s72, s72, s85
  s_or_b32 s72, s72, s86
  buffer_load_dwordx4 v3, s[44:47], s72 offen offset:0 nt lds
  buffer_load_dwordx4 v4, s[44:47], s72 offen offset:1024 nt lds
  buffer_load_dwordx4 v142, s[44:47], s72 offen offset:2048 nt lds
  buffer_load_dwordx4 v143, s[44:47], s72 offen offset:3072 nt lds
  s_add_u32 m0, m0, 4096
  s_nop 0
  buffer_load_dwordx4 v3, s[48:51], s72 offen offset:0 nt lds
  buffer_load_dwordx4 v4, s[48:51], s72 offen offset:1024 nt lds
  buffer_load_dwordx4 v142, s[48:51], s72 offen offset:2048 nt lds
  buffer_load_dwordx4 v143, s[48:51], s72 offen offset:3072 nt lds
  s_add_u32 s61, s61, s62
  s_movk_i32 s87, 0x2000
  s_branch L_noref
L_sdone:
  v_readfirstlane_b32 s9, v145
  s_mov_b32 s65, 2
  s_cmp_lg_u32 s9, 3
  s_cbranch_scc1 L_wo
  s_barrier
  s_mov_b32 s65, 3
L_wo:
  s_mov_b32 s44, s24
  s_and_b32 s45, s25, 0xffff
  s_mov_b32 s46, 4194304
  s_mov_b32 s48, s34
  s_and_b32 s49, s35, 0xffff
  s_mov_b32 s50, 4194304
  s_mov_b32 s73, s52
  s_mov_b32 s81, 0
  s_mov_b32 s86, 0
  s_lshl_b32 s60, s3, 13
  s_mov_b32 s87, 131072
  v_mov_b32 v3, v138
  v_mov_b32 v4, v139
  v_mov_b32 v142, v140
  v_mov_b32 v143, v141
  s_branch L_iss
L_wodone:
  s_cmp_eq_u32 s65, 3
  s_cbranch_scc1 L_wait
  s_barrier
L_wait:
  s_waitcnt vmcnt(0)
  s_barrier
  s_endpgm
L_helper:
  s_mov_b32 s47, 100000
  v_lshrrev_b32 v3, 3, v0
  v_lshlrev_b32 v3, 13, v3
  v_and_b32 v4, 7, v0
  v_lshl_add_u32 v3, v4, 4, v3
  s_and_b32 s11, s5, 1
  s_lshr_b32 s12, s5, 1
  s_lshl_b32 s8, s7, 10
  s_lshl_b32 s9, s12, 7
  s_add_u32 s8, s8, s9
  s_lshl_b32 s9, s11, 21
  s_add_u32 s8, s8, s9
  s_lshl_b32 s9, s3, 19
  s_add_u32 s8, s8, s9
  s_lshl_b32 s9, s3, 13
  s_add_u32 m0, s9, 131072
  s_mov_b32 s50, 0x400000
  s_mov_b32 s51, 0x20000
  v_and_b32 v4, 1, v2
  v_lshlrev_b32 v4, 10, v4
  v_lshl_add_u32 v4, v1, 4, v4
  s_lshl_b32 s9, s11, 9
  v_add_u32 v4, s9, v4
  s_cmp_eq_u32 s6, 0
  s_waitcnt lgkmcnt(0)
  s_cselect_b32 s48, s22, s32
  s_cselect_b32 s49, s23, s33
  s_and_b32 s49, s49, 0xffff
  s_load_dword s44, s[42:43], 0
  buffer_load_dwordx4 v3, s[48:51], s8 offen nt lds
  s_add_u32 m0, m0, 1024
  s_add_u32 s8, s8, 65536
  buffer_load_dwordx4 v3, s[48:51], s8 offen nt lds
  s_add_u32 m0, m0, 1024
  s_add_u32 s8, s8, 65536
  buffer_load_dwordx4 v3, s[48:51], s8 offen nt lds
  s_add_u32 m0, m0, 1024
  s_add_u32 s8, s8, 65536
  buffer_load_dwordx4 v3, s[48:51], s8 offen nt lds
  s_add_u32 m0, m0, 1024
  s_add_u32 s8, s8, 65536
  buffer_load_dwordx4 v3, s[48:51], s8 offen nt lds
  s_add_u32 m0, m0, 1024
  s_add_u32 s8, s8, 65536
  buffer_load_dwordx4 v3, s[48:51], s8 offen nt lds
  s_add_u32 m0, m0, 1024
  s_add_u32 s8, s8, 65536
  buffer_load_dwordx4 v3, s[48:51], s8 offen nt lds
  s_add_u32 m0, m0, 1024
  s_add_u32 s8, s8, 65536
  buffer_load_dwordx4 v3, s[48:51], s8 offen nt lds
  s_barrier
  s_xor_b32 s9, s6, 1
  s_or_b32 s9, s9, s5
  s_or_b32 s9, s9, s3
  s_cmp_lg_u32 s9, 0
  s_cbranch_scc1 L_nozero
  s_lshl_b32 s8, s7, 10
  s_add_u32 s8, s8, 4096
  v_and_b32 v5, 3, v0
  v_lshlrev_b32 v5, 8, v5
  v_lshrrev_b32 v6, 2, v0
  v_lshl_add_u32 v5, v6, 13, v5
  v_add_u32 v5, s8, v5
  v_mov_b32 v6, 0
  s_mov_b64 exec, 0xff
  global_store_dword v5, v6, s[42:43] sc1
  s_mov_b64 exec, -1
L_nozero:
  global_load_dwordx4 v[16:19], v4, s[16:17] offset:0
  global_load_dwordx4 v[20:23], v4, s[16:17] offset:64
  global_load_dwordx4 v[24:27], v4, s[16:17] offset:128
  global_load_dwordx4 v[28:31], v4, s[16:17] offset:192
  global_load_dwordx4 v[32:35], v4, s[16:17] offset:256
  global_load_dwordx4 v[36:39], v4, s[16:17] offset:320
  global_load_dwordx4 v[40:43], v4, s[16:17] offset:384
  global_load_dwordx4 v[44:47], v4, s[16:17] offset:448
  v_lshlrev_b32 v14, 5, v0
  v_and_b32 v15, 0x3ff, v14
  global_load_dwordx4 v[128:131], v14, s[16:17]
  global_load_dwordx4 v[132:135], v14, s[16:17] offset:16
  global_load_dwordx4 v[136:139], v15, s[36:37]
  global_load_dwordx4 v[140:143], v15, s[36:37] offset:16
  v_mov_b32 v9, 0xffffff00
  v_lshrrev_b32 v5, 2, v2
  v_lshl_add_u32 v5, v1, 3, v5
  v_lshlrev_b32 v5, 7, v5
  v_and_b32 v6, 3, v2
  v_lshl_add_u32 v5, v6, 3, v5
  s_lshl_b32 s9, s3, 5
  s_add_u32 s9, s9, 131072
  v_add_u32 v5, s9, v5
  s_lshl_b32 s8, s7, 14
  s_lshl_b32 s9, s6, 12
  s_add_u32 s8, s8, s9
  s_lshl_b32 s9, s11, 11
  s_add_u32 s8, s8, s9
  s_lshl_b32 s9, s12, 8
  s_add_u32 s8, s8, s9
  s_lshl_b32 s9, s3, 6
  s_add_u32 s8, s8, s9
  s_add_u32 s8, s8, 32768
  v_lshlrev_b32 v6, 13, v2
  v_lshl_add_u32 v6, v1, 4, v6
  v_add_u32 v6, s8, v6
  s_waitcnt vmcnt(4) lgkmcnt(0)
  s_add_u32 s46, s44, 1
  s_and_b32 s44, s46, 0xff
  s_barrier
  ds_read_b64_tr_b16 v[48:49], v5 offset:0
  ds_read_b64_tr_b16 v[50:51], v5 offset:512
  ds_read_b64_tr_b16 v[52:53], v5 offset:4096
  ds_read_b64_tr_b16 v[54:55], v5 offset:4608
  ds_read_b64_tr_b16 v[56:57], v5 offset:8192
  ds_read_b64_tr_b16 v[58:59], v5 offset:8704
  ds_read_b64_tr_b16 v[60:61], v5 offset:12288
  ds_read_b64_tr_b16 v[62:63], v5 offset:12800
  ds_read_b64_tr_b16 v[64:65], v5 offset:16384
  ds_read_b64_tr_b16 v[66:67], v5 offset:16896
  ds_read_b64_tr_b16 v[68:69], v5 offset:20480
  ds_read_b64_tr_b16 v[70:71], v5 offset:20992
  s_waitcnt lgkmcnt(10)
  ds_read_b64_tr_b16 v[72:73], v5 offset:24576
  ds_read_b64_tr_b16 v[74:75], v5 offset:25088
  v_mfma_f32_16x16x32_bf16 v[112:115], v[48:51], v[16:19], 0
  s_waitcnt lgkmcnt(10)
  ds_read_b64_tr_b16 v[76:77], v5 offset:28672
  ds_read_b64_tr_b16 v[78:79], v5 offset:29184
  v_mfma_f32_16x16x32_bf16 v[116:119], v[52:55], v[20:23], 0
  s_waitcnt lgkmcnt(10)
  v_mfma_f32_16x16x32_bf16 v[112:115], v[56:59], v[24:27], v[112:115]
  s_waitcnt lgkmcnt(8)
  v_mfma_f32_16x16x32_bf16 v[116:119], v[60:63], v[28:31], v[116:119]
  s_waitcnt lgkmcnt(6)
  v_mfma_f32_16x16x32_bf16 v[112:115], v[64:67], v[32:35], v[112:115]
  s_waitcnt lgkmcnt(4)
  v_mfma_f32_16x16x32_bf16 v[116:119], v[68:71], v[36:39], v[116:119]
  s_waitcnt lgkmcnt(2)
  v_mfma_f32_16x16x32_bf16 v[112:115], v[72:75], v[40:43], v[112:115]
  s_waitcnt lgkmcnt(0)
  v_mfma_f32_16x16x32_bf16 v[116:119], v[76:79], v[44:47], v[116:119]
  s_barrier
  s_nop 6
  v_add_f32 v112, v112, v116
  v_add_f32 v113, v113, v117
  v_add_f32 v114, v114, v118
  v_add_f32 v115, v115, v119
  v_bfi_b32 v112, v9, v112, s44
  v_bfi_b32 v113, v9, v113, s44
  v_bfi_b32 v114, v9, v114, s44
  v_bfi_b32 v115, v9, v115, s44
  s_mov_b32 exec_lo, 0x00030003
  s_mov_b32 exec_hi, 0x00030003
  global_store_dwordx4 v6, v[112:115], s[42:43] sc1
  s_mov_b64 exec, -1
  s_lshl_b32 s8, s7, 14
  s_lshl_b32 s9, s6, 13
  s_add_u32 s8, s8, s9
  s_lshr_b32 s9, s3, 1
  s_lshl_b32 s9, s9, 12
  s_add_u32 s8, s8, s9
  s_and_b32 s9, s3, 1
  s_lshl_b32 s9, s9, 10
  s_add_u32 s8, s8, s9
  s_add_u32 s8, s8, 32768
  v_lshlrev_b32 v86, 4, v0
  v_add_u32 v86, s8, v86
  s_lshl_b32 s9, s3, 9
  s_add_u32 s9, s9, 131072
  v_lshlrev_b32 v87, 3, v0
  v_add_u32 v87, s9, v87
  s_cmp_lt_u32 s3, 2
  s_cselect_b32 s9, s13, 0
  s_cmp_lg_u32 s9, 0
  s_cbranch_scc1 L_noq
L_pollQ:
  s_sleep 40
  global_load_dwordx4 v[48:51], v86, s[42:43] sc1
  global_load_dwordx4 v[52:55], v86, s[42:43] offset:2048 sc1
  s_waitcnt vmcnt(0)
  v_xor_b32 v20, s44, v48
  v_xor_b32 v21, s44, v49
  v_bitop3_b32 v20, v50, s44, v20 bitop3:0xbe
  v_bitop3_b32 v21, v51, s44, v21 bitop3:0xbe
  v_bitop3_b32 v20, v52, s44, v20 bitop3:0xbe
  v_bitop3_b32 v21, v53, s44, v21 bitop3:0xbe
  v_bitop3_b32 v20, v54, s44, v20 bitop3:0xbe
  v_bitop3_b32 v21, v55, s44, v21 bitop3:0xbe
  v_or_b32 v20, v20, v21
  v_and_b32 v20, 0xff, v20
  v_cmp_ne_u32 vcc, 0, v20
  s_cbranch_vccz L_okQ
  s_sub_u32 s47, s47, 1
  s_cmp_le_i32 s47, 0
  s_cbranch_scc1 L_okQ
  s_branch L_pollQ
L_okQ:
  v_pk_add_f32 v[48:49], v[48:49], v[52:53]
  v_pk_add_f32 v[50:51], v[50:51], v[54:55]
  v_cvt_pk_bf16_f32 v48, v48, v49
  v_cvt_pk_bf16_f32 v49, v50, v51
  ds_write_b64 v87, v[48:49]
  s_waitcnt lgkmcnt(0)
L_noq:
  s_barrier
  s_and_b32 s52, s5, 7
  s_lshr_b32 s53, s5, 3
  s_lshl_b32 s9, s6, 1
  s_add_u32 s53, s53, s9
  s_lshl_b32 s9, s7, 3
  s_add_u32 s54, s9, s52
  v_lshrrev_b32 v18, 2, v2
  s_lshl_b32 s9, s3, 1
  v_xor_b32 v13, s9, v18
  v_lshlrev_b32 v13, 5, v13
  v_lshl_add_u32 v18, v18, 8, v13
  v_and_b32 v13, 1, v1
  v_lshl_add_u32 v18, v13, 11, v18
  v_lshrrev_b32 v13, 1, v1
  v_lshl_add_u32 v18, v13, 13, v18
  v_and_b32 v13, 3, v2
  v_lshl_add_u32 v18, v13, 3, v18
  v_add_u32 v18, 131072, v18
  v_xor_b32 v82, 32, v18
  v_xor_b32 v83, 0x80, v18
  v_xor_b32 v84, 0xa0, v18
  s_mov_b32 s45, 0
  s_mov_b32 s63, 0
  s_mov_b32 s85, 0
  s_mov_b32 s80, 0
  s_mov_b32 s81, 0xff800000
  s_mov_b32 s82, 0x7f800000
  s_mov_b32 s64, s42
  s_and_b32 s65, s43, 0xffff
  s_mov_b32 s66, 1572864
  s_mov_b32 s67, 0x20000
  s_mov_b32 s68, s42
  s_and_b32 s69, s43, 0xffff
  s_cmp_eq_u32 s13, 0
  s_cselect_b32 s70, 1572864, 0
  s_mov_b32 s71, 0x20000
  s_mov_b32 s72, s42
  s_and_b32 s73, s43, 0xffff
  s_mov_b32 s74, 0
  s_mov_b32 s75, 0x20000
  s_mov_b32 s76, s38
  s_and_b32 s77, s39, 0xffff
  s_mov_b32 s78, 0
  s_mov_b32 s79, 0x20000
  s_lshl_b32 s9, s3, 7
  s_add_u32 s9, s9, 24576
  v_lshlrev_b32 v3, 9, v1
  v_lshl_add_u32 v3, v2, 3, v3
  v_add_u32 v3, s9, v3
  v_add_u32 v4, 0x10000, v3
  v_lshlrev_b32 v5, 3, v1
  v_add_u32 v5, 26624, v5
  v_add_u32 v6, 0x10000, v5
  s_lshl_b32 s9, s7, 3
  s_lshr_b32 s10, s3, 1
  s_add_u32 s9, s9, s10
  s_lshl_b32 s9, s9, 1
  s_add_u32 s9, s9, s6
  s_lshl_b32 s9, s9, 12
  s_and_b32 s10, s3, 1
  s_lshl_b32 s10, s10, 7
  s_add_u32 s9, s9, s10
  s_add_u32 s9, s9, 262144
  v_lshlrev_b32 v7, 14, v1
  v_lshl_add_u32 v7, v2, 3, v7
  v_add_u32 v7, s9, v7
  s_lshl_b32 s10, s5, 8
  s_add_u32 s83, s10, 0x80000
  s_lshl_b32 s84, s5, 7
  s_lshl_b32 s9, s54, 13
  s_lshr_b32 s10, s3, 1
  s_lshl_b32 s10, s10, 12
  s_add_u32 s9, s9, s10
  s_and_b32 s10, s3, 1
  s_lshl_b32 s10, s10, 7
  s_add_u32 s9, s9, s10
  s_add_u32 s9, s9, 262144
  v_lshlrev_b32 v10, 8, v1
  v_lshl_add_u32 v10, v2, 3, v10
  v_add_u32 v10, s9, v10
  v_mov_b32 v11, 0x7f000000
  s_lshl_b32 s9, s54, 12
  s_lshl_b32 s10, s53, 9
  s_add_u32 s9, s9, s10
  s_lshl_b32 s10, s3, 7
  s_add_u32 s9, s9, s10
  s_add_u32 s9, s9, 1310720
  v_and_b32 v12, 1, v2
  v_lshlrev_b32 v12, 11, v12
  v_lshrrev_b32 v13, 1, v2
  v_lshl_add_u32 v12, v13, 6, v12
  v_lshl_add_u32 v12, v1, 4, v12
  v_add_u32 v12, s9, v12
  v_cmp_eq_u32 s[56:57], 1, v13
  s_lshr_b32 s58, s2, 3
  s_xor_b32 s59, s2, s58
  s_and_b32 s59, s59, 7
  s_lshl_b32 s9, s58, 7
  s_add_u32 s9, s9, 1310720
  s_lshl_b32 s10, s3, 16
  s_add_u32 s9, s9, s10
  v_lshrrev_b32 v13, 3, v0
  v_lshlrev_b32 v13, 12, v13
  v_and_b32 v20, 7, v0
  v_lshl_add_u32 v13, v20, 4, v13
  v_add_u32 v120, s9, v13
  v_add_u32 v121, 32768, v120
  s_lshl_b32 s9, s3, 7
  s_add_u32 s9, s9, 27648
  v_lshlrev_b32 v122, 4, v20
  v_add_u32 v123, 27648, v122
  v_add_u32 v122, s9, v122
  s_lshl_b32 s9, s58, 6
  v_lshlrev_b32 v118, 3, v20
  v_add_u32 v118, s9, v118
  s_lshl_b32 s9, s3, 6
  s_add_u32 s9, s9, 26880
  v_lshlrev_b32 v15, 2, v2
  v_add_u32 v15, s9, v15
  v_and_b32 v16, 1, v2
  v_lshlrev_b32 v16, 7, v16
  v_lshl_add_u32 v16, v1, 4, v16
  v_add_u32 v16, 26880, v16
  v_mov_b32 v19, 27392
  s_waitcnt vmcnt(0)
  v_lshlrev_b32 v20, 16, v128
  v_and_b32 v21, 0xffff0000, v128
  v_lshlrev_b32 v22, 16, v136
  v_and_b32 v23, 0xffff0000, v136
  v_mul_f32 v20, v20, v22
  v_mul_f32 v21, v21, v23
  v_cvt_pk_bf16_f32 v20, v20, v21
  v_lshlrev_b32 v22, 16, v20
  v_and_b32 v23, 0xffff0000, v20
  v_add_f32 v112, v22, v23
  v_lshlrev_b32 v20, 16, v129
  v_and_b32 v21, 0xffff0000, v129
  v_lshlrev_b32 v22, 16, v137
  v_and_b32 v23, 0xffff0000, v137
  v_mul_f32 v20, v20, v22
  v_mul_f32 v21, v21, v23
  v_cvt_pk_bf16_f32 v20, v20, v21
  v_lshlrev_b32 v22, 16, v20
  v_and_b32 v23, 0xffff0000, v20
  v_add_f32 v112, v112, v22
  v_add_f32 v112, v112, v23
  v_lshlrev_b32 v20, 16, v130
  v_and_b32 v21, 0xffff0000, v130
  v_lshlrev_b32 v22, 16, v138
  v_and_b32 v23, 0xffff0000, v138
  v_mul_f32 v20, v20, v22
  v_mul_f32 v21, v21, v23
  v_cvt_pk_bf16_f32 v20, v20, v21
  v_lshlrev_b32 v22, 16, v20
  v_and_b32 v23, 0xffff0000, v20
  v_add_f32 v112, v112, v22
  v_add_f32 v112, v112, v23
  v_lshlrev_b32 v20, 16, v131
  v_and_b32 v21, 0xffff0000, v131
  v_lshlrev_b32 v22, 16, v139
  v_and_b32 v23, 0xffff0000, v139
  v_mul_f32 v20, v20, v22
  v_mul_f32 v21, v21, v23
  v_cvt_pk_bf16_f32 v20, v20, v21
  v_lshlrev_b32 v22, 16, v20
  v_and_b32 v23, 0xffff0000, v20
  v_add_f32 v112, v112, v22
  v_add_f32 v112, v112, v23
  v_lshlrev_b32 v20, 16, v132
  v_and_b32 v21, 0xffff0000, v132
  v_lshlrev_b32 v22, 16, v140
  v_and_b32 v23, 0xffff0000, v140
  v_mul_f32 v20, v20, v22
  v_mul_f32 v21, v21, v23
  v_cvt_pk_bf16_f32 v20, v20, v21
  v_lshlrev_b32 v22, 16, v20
  v_and_b32 v23, 0xffff0000, v20
  v_add_f32 v112, v112, v22
  v_add_f32 v112, v112, v23
  v_lshlrev_b32 v20, 16, v133
  v_and_b32 v21, 0xffff0000, v133
  v_lshlrev_b32 v22, 16, v141
  v_and_b32 v23, 0xffff0000, v141
  v_mul_f32 v20, v20, v22
  v_mul_f32 v21, v21, v23
  v_cvt_pk_bf16_f32 v20, v20, v21
  v_lshlrev_b32 v22, 16, v20
  v_and_b32 v23, 0xffff0000, v20
  v_add_f32 v112, v112, v22
  v_add_f32 v112, v112, v23
  v_lshlrev_b32 v20, 16, v134
  v_and_b32 v21, 0xffff0000, v134
  v_lshlrev_b32 v22, 16, v142
  v_and_b32 v23, 0xffff0000, v142
  v_mul_f32 v20, v20, v22
  v_mul_f32 v21, v21, v23
  v_cvt_pk_bf16_f32 v20, v20, v21
  v_lshlrev_b32 v22, 16, v20
  v_and_b32 v23, 0xffff0000, v20
  v_add_f32 v112, v112, v22
  v_add_f32 v112, v112, v23
  v_lshlrev_b32 v20, 16, v135
  v_and_b32 v21, 0xffff0000, v135
  v_lshlrev_b32 v22, 16, v143
  v_and_b32 v23, 0xffff0000, v143
  v_mul_f32 v20, v20, v22
  v_mul_f32 v21, v21, v23
  v_cvt_pk_bf16_f32 v20, v20, v21
  v_lshlrev_b32 v22, 16, v20
  v_and_b32 v23, 0xffff0000, v20
  v_add_f32 v112, v112, v22
  v_add_f32 v112, v112, v23
  s_nop 1
  v_add_f32_dpp v112, v112, v112 row_ror:8 row_mask:0xf bank_mask:0xf
  s_nop 1
  v_add_f32_dpp v112, v112, v112 row_ror:4 row_mask:0xf bank_mask:0xf
  s_nop 1
  v_add_f32_dpp v112, v112, v112 row_ror:2 row_mask:0xf bank_mask:0xf
  s_nop 1
  v_add_f32_dpp v112, v112, v112 row_ror:1 row_mask:0xf bank_mask:0xf
  v_mov_b32 v20, v112
  s_nop 1
  v_permlane16_swap_b32 v112, v20
  v_add_f32 v112, v112, v20
  v_cvt_pk_bf16_f32 v112, v112, v112
  v_lshlrev_b32 v112, 16, v112
  v_mul_f32 v112, 0xbfb8aa3b, v112
  v_exp_f32 v112, v112
  s_nop 0
  v_add_f32 v112, 1.0, v112
  v_rcp_f32 v112, v112
  s_nop 0
  v_cvt_pk_bf16_f32 v112, v112, v112
  v_lshlrev_b32 v112, 16, v112
  v_sub_f32 v113, 1.0, v112
  v_cvt_pk_bf16_f32 v113, v113, v113
  v_lshlrev_b32 v113, 16, v113
  s_lshr_b32 s9, s3, 1
  s_lshl_b32 s9, s9, 5
  s_nop 0
  v_readlane_b32 s10, v112, s9
  v_readlane_b32 s11, v113, s9
  s_nop 1
  v_mov_b32 v112, s10
  v_mov_b32 v113, s11
L_pass:
  s_barrier
  ds_read_b64 v[28:29], v5
  ds_read_b64 v[30:31], v5 offset:32768
  ds_read_b64 v[32:33], v6
  ds_read_b64 v[34:35], v6 offset:32768
  ds_read_b64 v[20:21], v3
  ds_read_b64 v[22:23], v3 offset:32768
  ds_read_b64 v[24:25], v4
  ds_read_b64 v[26:27], v4 offset:32768
  s_waitcnt lgkmcnt(4)
  v_max3_f32 v44, v28, v30, v32
  v_max_f32 v44, v44, v34
  v_sub_f32 v28, v28, v44
  v_sub_f32 v30, v30, v44
  v_sub_f32 v32, v32, v44
  v_sub_f32 v34, v34, v44
  v_exp_f32 v28, v28
  v_exp_f32 v30, v30
  v_exp_f32 v32, v32
  v_exp_f32 v34, v34
  v_mul_f32 v45, v28, v29
  v_fmac_f32 v45, v30, v31
  v_fmac_f32 v45, v32, v33
  v_fmac_f32 v45, v34, v35
  v_rcp_f32 v46, v45
  v_log_f32 v47, v45
  s_waitcnt lgkmcnt(0)
  v_pk_mul_f32 v[20:21], v[20:21], v[28:29] op_sel_hi:[1,0]
  v_pk_fma_f32 v[20:21], v[22:23], v[30:31], v[20:21] op_sel_hi:[1,0,1]
  v_pk_fma_f32 v[20:21], v[24:25], v[32:33], v[20:21] op_sel_hi:[1,0,1]
  v_pk_fma_f32 v[20:21], v[26:27], v[34:35], v[20:21] op_sel_hi:[1,0,1]
  v_add_f32 v47, v44, v47
  v_pk_mul_f32 v[20:21], v[20:21], v[46:47] op_sel_hi:[1,0]
  v_bfi_b32 v47, v9, v47, s44
  v_cvt_pk_bf16_f32 v46, v20, v21
  buffer_store_dwordx2 v[46:47], v7, s[68:71], s84 offen sc1
  s_cmp_lg_u32 s45, 0
  s_cbranch_scc1 L_pollP
  v_mov_b32 v20, 0
  ds_write_b32 v19, v20
  s_waitcnt lgkmcnt(0)
  s_barrier
L_pollP:
  buffer_load_dwordx2 v[48:49], v10, s[64:67], 0 offen offset:0 sc1
  buffer_load_dwordx2 v[50:51], v11, s[64:67], 0 offen offset:1024 sc1
  buffer_load_dwordx2 v[52:53], v11, s[64:67], 0 offen offset:2048 sc1
  buffer_load_dwordx2 v[54:55], v11, s[64:67], 0 offen offset:3072 sc1
  s_waitcnt vmcnt(0)
  v_xor_b32 v21, s44, v51
  v_xor_b32 v20, s44, v49
  v_bitop3_b32 v21, v53, s44, v21 bitop3:0xbe
  v_max3_f32 v22, v51, v53, v55
  v_bitop3_b32 v21, v55, s44, v21 bitop3:0xbe
  v_add_f32 v22, s81, v22
  v_and_or_b32 v20, v21, s80, v20
  v_max_f32 v22, v22, v49
  v_and_b32 v20, 0xff, v20
  v_cmp_ne_u32 vcc, 0, v20
  s_cbranch_vccz L_okP
  s_sub_u32 s47, s47, 1
  s_cmp_le_i32 s47, 0
  s_cbranch_scc1 L_okP
  s_sleep 1
  s_branch L_pollP
L_okP:
  v_mov_b32 v23, v22
  v_and_b32 v57, 0xffff0000, v48
  v_lshlrev_b32 v56, 16, v48
  v_permlane16_swap_b32 v22, v23
  v_max_f32 v22, v22, v23
  v_mov_b32 v23, v22
  v_and_b32 v59, 0xffff0000, v50
  v_lshlrev_b32 v58, 16, v50
  v_permlane32_swap_b32 v22, v23
  v_max_f32 v22, v22, v23
  v_add_f32 v23, s82, v22
  v_sub_f32 v104, v49, v22
  v_sub_f32 v105, v51, v23
  v_sub_f32 v106, v53, v23
  v_sub_f32 v107, v55, v23
  v_exp_f32 v104, v104
  v_exp_f32 v105, v105
  v_exp_f32 v106, v106
  v_exp_f32 v107, v107
  v_and_b32 v61, 0xffff0000, v52
  v_lshlrev_b32 v60, 16, v52
  v_and_b32 v63, 0xffff0000, v54
  v_lshlrev_b32 v62, 16, v54
  v_pk_mul_f32 v[24:25], v[56:57], v[104:105] op_sel_hi:[1,0]
  v_pk_mul_f32 v[26:27], v[58:59], v[104:105] op_sel:[0,1] op_sel_hi:[1,1]
  v_pk_fma_f32 v[24:25], v[60:61], v[106:107], v[24:25] op_sel_hi:[1,0,1]
  v_pk_fma_f32 v[26:27], v[62:63], v[106:107], v[26:27] op_sel:[0,1,0] op_sel_hi:[1,1,1]
  v_pk_add_f32 v[104:105], v[104:105], v[106:107]
  v_pk_add_f32 v[24:25], v[24:25], v[26:27]
  v_add_f32 v26, v104, v105
  v_mov_b32 v28, v24
  v_mov_b32 v29, v25
  v_mov_b32 v30, v26
  s_nop 0
  v_permlane16_swap_b32 v24, v28
  v_permlane16_swap_b32 v25, v29
  v_permlane16_swap_b32 v26, v30
  v_add_f32 v26, v26, v30
  v_pk_add_f32 v[24:25], v[24:25], v[28:29]
  v_mov_b32 v28, v24
  v_mov_b32 v29, v25
  v_mov_b32 v30, v26
  s_nop 0
  v_permlane32_swap_b32 v24, v28
  v_permlane32_swap_b32 v25, v29
  v_permlane32_swap_b32 v26, v30
  v_add_f32 v26, v26, v30
  v_pk_add_f32 v[24:25], v[24:25], v[28:29]
  v_rcp_f32 v26, v26
  v_pk_mul_f32 v[24:25], v[24:25], v[112:113] op_sel_hi:[1,0]
  v_pk_mul_f32 v[24:25], v[24:25], v[26:27] op_sel_hi:[1,0]
  v_cvt_pk_bf16_f32 v24, v24, v25
  ds_write_b32 v15, v24
  s_waitcnt lgkmcnt(0)
  s_barrier
  ds_read_b64_tr_b16 v[144:145], v18 offset:0
  ds_read_b64_tr_b16 v[146:147], v83 offset:1024
  ds_read_b64_tr_b16 v[152:153], v82 offset:0
  ds_read_b64_tr_b16 v[154:155], v84 offset:1024
  ds_read_b64_tr_b16 v[148:149], v18 offset:16384
  ds_read_b64_tr_b16 v[150:151], v83 offset:17408
  ds_read_b64_tr_b16 v[156:157], v82 offset:16384
  ds_read_b64_tr_b16 v[158:159], v84 offset:17408
  ds_read_b128 v[28:31], v16 offset:256
  ds_read_b64_tr_b16 v[160:161], v18 offset:4096
  ds_read_b64_tr_b16 v[162:163], v83 offset:5120
  ds_read_b64_tr_b16 v[168:169], v82 offset:4096
  ds_read_b64_tr_b16 v[170:171], v84 offset:5120
  s_waitcnt lgkmcnt(9)
  v_mfma_f32_16x16x32_bf16 v[36:39], v[144:147], v[96:99], 0
  v_mfma_f32_16x16x32_bf16 v[40:43], v[152:155], v[96:99], 0
  ds_read_b128 v[32:35], v16 offset:320
  ds_read_b64_tr_b16 v[164:165], v18 offset:20480
  ds_read_b64_tr_b16 v[166:167], v83 offset:21504
  ds_read_b64_tr_b16 v[172:173], v82 offset:20480
  ds_read_b64_tr_b16 v[174:175], v84 offset:21504
  s_waitcnt lgkmcnt(10)
  v_mfma_f32_16x16x32_bf16 v[36:39], v[148:151], v[100:103], v[36:39]
  v_mfma_f32_16x16x32_bf16 v[40:43], v[156:159], v[100:103], v[40:43]
  s_waitcnt lgkmcnt(5)
  v_mfma_f32_16x16x32_bf16 v[36:39], v[160:163], v[28:31], v[36:39]
  v_mfma_f32_16x16x32_bf16 v[40:43], v[168:171], v[28:31], v[40:43]
  s_waitcnt lgkmcnt(0)
  v_mfma_f32_16x16x32_bf16 v[36:39], v[164:167], v[32:35], v[36:39]
  v_mfma_f32_16x16x32_bf16 v[40:43], v[172:175], v[32:35], v[40:43]
  s_mov_b32 exec_lo, 0x000f000f
  s_mov_b32 exec_hi, 0x000f000f
  s_nop 5
  v_cndmask_b32 v44, v36, v40, s[56:57]
  v_cndmask_b32 v45, v37, v41, s[56:57]
  v_cndmask_b32 v46, v38, v42, s[56:57]
  v_cndmask_b32 v47, v39, v43, s[56:57]
  v_bfi_b32 v44, v9, v44, s44
  v_bfi_b32 v45, v9, v45, s44
  v_bfi_b32 v46, v9, v46, s44
  v_bfi_b32 v47, v9, v47, s44
  buffer_store_dwordx4 v[44:47], v12, s[72:75], 0 offen sc1
  s_mov_b64 exec, -1
  s_cmp_lg_u32 s59, 0
  s_cbranch_scc1 L_nofinal
L_pollF:
  buffer_load_dwordx4 v[48:51], v120, s[72:75], 0 offen sc1
  buffer_load_dwordx4 v[52:55], v121, s[72:75], 0 offen sc1
  s_waitcnt vmcnt(0)
  v_xor_b32 v20, s44, v48
  v_xor_b32 v21, s44, v49
  v_bitop3_b32 v20, v50, s44, v20 bitop3:0xbe
  v_bitop3_b32 v21, v51, s44, v21 bitop3:0xbe
  v_bitop3_b32 v20, v52, s44, v20 bitop3:0xbe
  v_bitop3_b32 v21, v53, s44, v21 bitop3:0xbe
  v_bitop3_b32 v20, v54, s44, v20 bitop3:0xbe
  v_bitop3_b32 v21, v55, s44, v21 bitop3:0xbe
  v_or_b32 v20, v20, v21
  v_and_b32 v20, 0xff, v20
  v_cmp_ne_u32 vcc, 0, v20
  s_cbranch_vccz L_okF
  s_sub_u32 s63, s63, 1
  s_cmp_le_i32 s63, 0
  s_cbranch_scc1 L_okF
  s_sleep 1
  s_branch L_pollF
L_okF:
  v_pk_add_f32 v[48:49], v[48:49], v[52:53]
  v_pk_add_f32 v[50:51], v[50:51], v[54:55]
  s_nop 0
  v_add_f32_dpp v48, v48, v48 row_ror:8 row_mask:0xf bank_mask:0xf
  v_add_f32_dpp v49, v49, v49 row_ror:8 row_mask:0xf bank_mask:0xf
  v_add_f32_dpp v50, v50, v50 row_ror:8 row_mask:0xf bank_mask:0xf
  v_add_f32_dpp v51, v51, v51 row_ror:8 row_mask:0xf bank_mask:0xf
  v_mov_b32 v28, v48
  v_mov_b32 v29, v49
  v_mov_b32 v30, v50
  v_mov_b32 v31, v51
  v_permlane16_swap_b32 v48, v28
  v_permlane16_swap_b32 v49, v29
  v_permlane16_swap_b32 v50, v30
  v_permlane16_swap_b32 v51, v31
  v_pk_add_f32 v[48:49], v[48:49], v[28:29]
  v_pk_add_f32 v[50:51], v[50:51], v[30:31]
  v_mov_b32 v28, v48
  v_mov_b32 v29, v49
  v_mov_b32 v30, v50
  v_mov_b32 v31, v51
  s_nop 0
  v_permlane32_swap_b32 v48, v28
  v_permlane32_swap_b32 v49, v29
  v_permlane32_swap_b32 v50, v30
  v_permlane32_swap_b32 v51, v31
  v_pk_add_f32 v[48:49], v[48:49], v[28:29]
  v_pk_add_f32 v[50:51], v[50:51], v[30:31]
  ds_write_b128 v122, v[48:51]
  s_waitcnt lgkmcnt(0)
  s_cmp_eq_u32 s45, 0
  s_cbranch_scc1 L_nofb
  s_barrier
L_nofb:
  s_cmp_lg_u32 s3, 0
  s_cbranch_scc1 L_nofinal
  ds_read_b128 v[52:55], v123 offset:128
  ds_read_b128 v[56:59], v123 offset:256
  ds_read_b128 v[60:63], v123 offset:384
  s_waitcnt lgkmcnt(1)
  v_pk_add_f32 v[48:49], v[48:49], v[52:53]
  v_pk_add_f32 v[50:51], v[50:51], v[54:55]
  v_pk_add_f32 v[48:49], v[48:49], v[56:57]
  v_pk_add_f32 v[50:51], v[50:51], v[58:59]
  s_waitcnt lgkmcnt(0)
  v_pk_add_f32 v[48:49], v[48:49], v[60:61]
  v_pk_add_f32 v[50:51], v[50:51], v[62:63]
  v_cvt_pk_bf16_f32 v28, v48, v49
  v_cvt_pk_bf16_f32 v29, v50, v51
  s_mov_b64 exec, 0xff
  buffer_store_dwordx2 v[28:29], v118, s[76:79], 0 offen
  s_mov_b64 exec, -1
L_nofinal:
  s_cmp_lg_u32 s45, 0
  s_cbranch_scc1 L_fin
  s_mov_b32 s45, 1
  s_mov_b32 s63, 100000
  s_mov_b32 s80, 0xff
  s_mov_b32 s85, 1
  s_mov_b32 s81, 0
  s_mov_b32 s82, 0
  s_mov_b32 s84, s83
  s_mov_b32 s70, 1572864
  s_mov_b32 s74, 1572864
  s_mov_b32 s78, 2048
  v_mov_b32 v112, v113
  v_add_u32 v3, 4096, v3
  v_add_u32 v4, 4096, v4
  v_add_u32 v5, 4096, v5
  v_add_u32 v6, 4096, v6
  v_add_u32 v10, 0x80000, v10
  v_mov_b32 v11, v10
  v_add_u32 v15, 256, v15
  buffer_load_dwordx2 v[46:47], v7, s[64:67], s84 offen sc1
  s_mov_b32 exec_lo, 0x000f000f
  s_mov_b32 exec_hi, 0x000f000f
  buffer_load_dwordx4 v[40:43], v12, s[64:67], 0 offen sc1
  s_mov_b64 exec, -1
  ds_read_b128 v[96:99], v16
  ds_read_b128 v[100:103], v16 offset:64
  s_waitcnt vmcnt(0) lgkmcnt(0)
  s_branch L_pass
L_fin:
  s_or_b32 s9, s2, s3
  s_cmp_lg_u32 s9, 0
  s_cbranch_scc1 L_noe
  v_mov_b32 v31, 0
  v_mov_b32 v32, s46
  s_mov_b64 exec, 1
  global_store_dword v31, v32, s[42:43]
L_noe:
L_end:
  s_endpgm
.section .rodata,"a"
.p2align 6
.amdhsa_kernel gated_mix__sliding_block_cached__gqa_block_cached__decode_kernel
  .amdhsa_next_free_vgpr 176
  .amdhsa_next_free_sgpr 96
  .amdhsa_accum_offset 176
  .amdhsa_group_segment_fixed_size 0
  .amdhsa_kernarg_size 112
  .amdhsa_user_sgpr_count 2
  .amdhsa_user_sgpr_kernarg_segment_ptr 1
  .amdhsa_system_sgpr_workgroup_id_x 1
  .amdhsa_float_denorm_mode_32 3
.end_amdhsa_kernel
```
